```python
import torch

def _softmax(x, axis=-1):
    return torch.softmax(x, dim=axis)
def _gelu(x):
    return torch.nn.functional.gelu(x, approximate="tanh")
def _silu(x):
    return torch.nn.functional.silu(x)
def _sigmoid(x):
    return torch.sigmoid(x)
def _layernorm(x, axis=-1, eps=1e-5):
    m = x.mean(dim=axis, keepdim=True)
    v = x.var(dim=axis, keepdim=True, unbiased=False)
    return (x - m) / torch.sqrt(v + eps)
def _scatter_add(tgt, idx, src, axis=0):
    return tgt.clone().index_add_(axis, idx, src)
def _segment_sum(src, seg, n):
    out = torch.zeros((n,) + src.shape[1:], dtype=src.dtype)
    return out.index_add_(0, seg, src)
def _pad(x, pw):
    flat = tuple(v for pair in reversed(pw) for v in pair)
    return torch.nn.functional.pad(x, flat)

kernel_name = 'standalone__glu_gated_swiglu__decode'

def setup_inputs():

    _w = (lambda a: (lambda t: t.to(torch.bfloat16) if t.is_floating_point() else t)(torch.as_tensor(a)))
    B, S, D, F = 1, 1, 1024, 3584
    return {
        "x": _w((lambda *s: torch.randn(*s, dtype=torch.bfloat16) * 0.05)(B, S, D)),
        "w1": _w((lambda *s: torch.randn(*s, dtype=torch.bfloat16) * 0.05)(D, F) * (2.0 / D) ** 0.5),
        "w3": _w((lambda *s: torch.randn(*s, dtype=torch.bfloat16) * 0.05)(D, F) * (2.0 / D) ** 0.5),
        "w2": _w((lambda *s: torch.randn(*s, dtype=torch.bfloat16) * 0.05)(F, D) * (2.0 / F) ** 0.5),
    }

def reference(x, w1, w3, w2):
    gate = torch.einsum("bsd,df->bsf", x, w1)
    up = torch.einsum("bsd,df->bsf", x, w3)
    h = _silu(gate) * up
    out = torch.einsum("bsf,fd->bsd", h, w2)
    return out
```

```asm
; @launch grid=(256,1,1) block=(512,1,1) lds=2304
.amdgcn_target "amdgcn-amd-amdhsa--gfx950"
.text
.globl standalone__glu_gated_swiglu__decode_kernel
.p2align 8
.type standalone__glu_gated_swiglu__decode_kernel,@function
standalone__glu_gated_swiglu__decode_kernel:
    s_load_dwordx8 s[4:11], s[0:1], 0
    s_load_dwordx4 s[12:15], s[0:1], 32
    s_load_dwordx2 s[16:17], s[0:1], 48
    v_lshrrev_b32 v5, 6, v0
    s_and_b32 s3, s2, 7
    s_lshr_b32 s18, s2, 3
    v_readfirstlane_b32 s33, v5
    s_cmp_ge_u32 s2, 256
    s_cbranch_scc1 L_exit
    s_and_b32 s34, s18, 3
    s_lshr_b32 s19, s18, 2
    s_mul_i32 s24, s3, 7
    s_add_u32 s19, s19, s24
    s_sub_u32 s19, s19, 1
    s_cmp_ge_u32 s33, 4
    s_cbranch_scc1 L_hi
    s_and_b32 s55, s19, 7
    s_cmp_eq_u32 s55, 3
    s_cselect_b32 s55, 1, 0
    s_cselect_b32 s57, 0, 7340032
    s_mov_b32 s26, 7340032
    s_cmp_ge_u32 s18, 4
    s_cbranch_scc1 L_main
    s_cmp_eq_u32 s3, 4
    s_cbranch_scc1 L_exit
    s_lshl_b32 s19, s3, 3
    s_cmp_gt_u32 s3, 4
    s_cselect_b32 s24, -5, 3
    s_add_u32 s19, s19, s24
    s_mov_b32 s26, 0
    s_mov_b32 s57, 7340032
L_main:
    s_mul_i32 s24, s34, 1835008
    s_lshl_b32 s56, s19, 7
    s_add_u32 s24, s24, s56
    v_lshrrev_b32 v5, 3, v0
    v_mul_u32_u24 v1, 0xe000, v5
    v_and_b32 v6, 7, v0
    v_lshlrev_b32 v6, 4, v6
    v_add3_u32 v1, v1, v6, s24
    s_lshl_b32 s24, s34, 9
    v_lshl_add_u32 v2, v5, 4, s24
    s_mul_i32 s48, s3, 25
    s_add_u32 s48, s48, s19
    s_lshl_b32 s48, s48, 3
    v_mov_b32 v4, 2048
    v_mov_b32 v28, 0
    ds_write_b32 v4, v28
    s_mov_b32 s30, s26
    s_mov_b32 s27, 0x20000
    s_mov_b32 s31, 0x20000
    s_movk_i32 s41, 7168
    s_movk_i32 s42, 14336
    s_movk_i32 s43, 21504
    s_movk_i32 s44, 28672
    s_mov_b32 s45, 35840
    s_mov_b32 s46, 43008
    s_mov_b32 s47, 50176
    s_mov_b32 s22, 2048
    s_mov_b32 s23, 0x20000
    s_waitcnt lgkmcnt(0)
    s_mov_b64 s[20:21], s[4:5]
    s_mov_b64 s[24:25], s[6:7]
    s_mov_b64 s[28:29], s[8:9]
    s_load_dwordx2 s[58:59], s[16:17], s48
    buffer_load_dwordx4 v[8:11], v2, s[20:23], 0 offen
    buffer_load_dwordx4 v[48:51], v1, s[24:27], 0 offen nt
    buffer_load_dwordx4 v[52:55], v1, s[28:31], 0 offen nt
    buffer_load_dwordx4 v[56:59], v1, s[24:27], s41 offen nt
    buffer_load_dwordx4 v[60:63], v1, s[28:31], s41 offen nt
    buffer_load_dwordx4 v[64:67], v1, s[24:27], s42 offen nt
    buffer_load_dwordx4 v[68:71], v1, s[28:31], s42 offen nt
    buffer_load_dwordx4 v[72:75], v1, s[24:27], s43 offen nt
    buffer_load_dwordx4 v[76:79], v1, s[28:31], s43 offen nt
    s_mov_b32 s30, s57
    buffer_load_dwordx4 v[80:83], v1, s[24:27], s44 offen nt
    buffer_load_dwordx4 v[84:87], v1, s[28:31], s44 offen nt
    s_mov_b32 s26, s57
    buffer_load_dwordx4 v[88:91], v1, s[24:27], s45 offen nt
    buffer_load_dwordx4 v[92:95], v1, s[28:31], s45 offen nt
    buffer_load_dwordx4 v[96:99], v1, s[24:27], s46 offen nt
    buffer_load_dwordx4 v[100:103], v1, s[28:31], s46 offen nt
    buffer_load_dwordx4 v[104:107], v1, s[24:27], s47 offen nt
    buffer_load_dwordx4 v[108:111], v1, s[28:31], s47 offen nt
    s_mov_b64 s[20:21], s[16:17]
    s_mov_b32 s22, 1114112
    s_lshl_b32 s54, s3, 16
    s_add_u32 s54, s54, 66048
    s_lshl_b32 s50, s18, 11
    s_add_u32 s50, s50, s54
    v_and_b32 v6, 63, v0
    v_and_b32 v7, 32, v0
    v_add_u32 v7, v7, v6
    v_lshlrev_b32 v3, 4, v7
    s_barrier
    s_mov_b32 s35, 0x20000
    s_add_u32 s49, s54, 4096
    s_xor_b32 s51, s50, 0x800
    s_xor_b32 s52, s50, 0x1000
    s_xor_b32 s53, s50, 0x1800
    s_xor_b32 s40, s50, 0x200
    v_lshlrev_b32 v1, 1, v6
    v_lshlrev_b32 v2, 5, v6
    v_and_b32 v5, 7, v0
    v_bfe_u32 v6, v0, 3, 3
    v_lshl_add_u32 v5, v5, 3, v6
    s_lshl_b32 s24, s33, 3
    v_lshl_add_u32 v5, v5, 5, s24
    v_mov_b32 v46, 1
    s_waitcnt lgkmcnt(0)
    s_add_u32 s58, s58, 2135587861
    s_add_u32 s59, s59, 2654435769
    s_getreg_b32 s24, hwreg(HW_REG_XCC_ID, 0, 4)
    s_add_u32 s36, s58, s24
    s_mov_b32 s37, s59
    s_xor_b32 s38, s36, s58
    v_mov_b32 v114, s36
    v_mov_b32 v115, s59
    v_mov_b32 v118, s58
    v_mov_b32 v119, s59
    v_mov_b32 v29, 0
    v_mov_b32 v30, 0
    v_mov_b32 v31, 0
    v_mov_b32 v32, 0
    v_mov_b32 v33, 0
    v_mov_b32 v34, 0
    v_mov_b32 v35, 0
    v_mov_b32 v36, 0
    v_mov_b32 v37, 0
    v_mov_b32 v38, 0
    v_mov_b32 v39, 0
    v_mov_b32 v40, 0
    v_mov_b32 v41, 0
    v_mov_b32 v42, 0
    v_mov_b32 v43, 0
    s_waitcnt vmcnt(16)
    v_and_b32 v12, 0xffff, v8
    v_lshlrev_b32 v13, 16, v8
    v_lshrrev_b32 v14, 16, v8
    v_and_b32 v15, 0xffff0000, v8
    v_and_b32 v16, 0xffff, v9
    v_lshlrev_b32 v17, 16, v9
    v_lshrrev_b32 v18, 16, v9
    v_and_b32 v19, 0xffff0000, v9
    v_and_b32 v20, 0xffff, v10
    v_lshlrev_b32 v21, 16, v10
    v_lshrrev_b32 v22, 16, v10
    v_and_b32 v23, 0xffff0000, v10
    v_and_b32 v24, 0xffff, v11
    v_lshlrev_b32 v25, 16, v11
    v_lshrrev_b32 v26, 16, v11
    v_and_b32 v27, 0xffff0000, v11
    s_waitcnt vmcnt(15)
    v_dot2c_f32_bf16 v28, v12, v48
    v_dot2c_f32_bf16 v29, v13, v48
    v_dot2c_f32_bf16 v30, v12, v49
    v_dot2c_f32_bf16 v31, v13, v49
    v_dot2c_f32_bf16 v32, v12, v50
    v_dot2c_f32_bf16 v33, v13, v50
    v_dot2c_f32_bf16 v34, v12, v51
    v_dot2c_f32_bf16 v35, v13, v51
    s_waitcnt vmcnt(14)
    v_dot2c_f32_bf16 v36, v12, v52
    v_dot2c_f32_bf16 v37, v13, v52
    v_dot2c_f32_bf16 v38, v12, v53
    v_dot2c_f32_bf16 v39, v13, v53
    v_dot2c_f32_bf16 v40, v12, v54
    v_dot2c_f32_bf16 v41, v13, v54
    v_dot2c_f32_bf16 v42, v12, v55
    v_dot2c_f32_bf16 v43, v13, v55
    s_waitcnt vmcnt(13)
    v_dot2c_f32_bf16 v28, v14, v56
    v_dot2c_f32_bf16 v29, v15, v56
    v_dot2c_f32_bf16 v30, v14, v57
    v_dot2c_f32_bf16 v31, v15, v57
    v_dot2c_f32_bf16 v32, v14, v58
    v_dot2c_f32_bf16 v33, v15, v58
    v_dot2c_f32_bf16 v34, v14, v59
    v_dot2c_f32_bf16 v35, v15, v59
    s_waitcnt vmcnt(12)
    v_dot2c_f32_bf16 v36, v14, v60
    v_dot2c_f32_bf16 v37, v15, v60
    v_dot2c_f32_bf16 v38, v14, v61
    v_dot2c_f32_bf16 v39, v15, v61
    v_dot2c_f32_bf16 v40, v14, v62
    v_dot2c_f32_bf16 v41, v15, v62
    v_dot2c_f32_bf16 v42, v14, v63
    v_dot2c_f32_bf16 v43, v15, v63
    s_waitcnt vmcnt(11)
    v_dot2c_f32_bf16 v28, v16, v64
    v_dot2c_f32_bf16 v29, v17, v64
    v_dot2c_f32_bf16 v30, v16, v65
    v_dot2c_f32_bf16 v31, v17, v65
    v_dot2c_f32_bf16 v32, v16, v66
    v_dot2c_f32_bf16 v33, v17, v66
    v_dot2c_f32_bf16 v34, v16, v67
    v_dot2c_f32_bf16 v35, v17, v67
    s_waitcnt vmcnt(10)
    v_dot2c_f32_bf16 v36, v16, v68
    v_dot2c_f32_bf16 v37, v17, v68
    v_dot2c_f32_bf16 v38, v16, v69
    v_dot2c_f32_bf16 v39, v17, v69
    v_dot2c_f32_bf16 v40, v16, v70
    v_dot2c_f32_bf16 v41, v17, v70
    v_dot2c_f32_bf16 v42, v16, v71
    v_dot2c_f32_bf16 v43, v17, v71
    s_waitcnt vmcnt(9)
    v_dot2c_f32_bf16 v28, v18, v72
    v_dot2c_f32_bf16 v29, v19, v72
    v_dot2c_f32_bf16 v30, v18, v73
    v_dot2c_f32_bf16 v31, v19, v73
    v_dot2c_f32_bf16 v32, v18, v74
    v_dot2c_f32_bf16 v33, v19, v74
    v_dot2c_f32_bf16 v34, v18, v75
    v_dot2c_f32_bf16 v35, v19, v75
    s_waitcnt vmcnt(8)
    v_dot2c_f32_bf16 v36, v18, v76
    v_dot2c_f32_bf16 v37, v19, v76
    v_dot2c_f32_bf16 v38, v18, v77
    v_dot2c_f32_bf16 v39, v19, v77
    v_dot2c_f32_bf16 v40, v18, v78
    v_dot2c_f32_bf16 v41, v19, v78
    v_dot2c_f32_bf16 v42, v18, v79
    v_dot2c_f32_bf16 v43, v19, v79
    s_waitcnt vmcnt(7)
    v_dot2c_f32_bf16 v28, v20, v80
    v_dot2c_f32_bf16 v29, v21, v80
    v_dot2c_f32_bf16 v30, v20, v81
    v_dot2c_f32_bf16 v31, v21, v81
    v_dot2c_f32_bf16 v32, v20, v82
    v_dot2c_f32_bf16 v33, v21, v82
    v_dot2c_f32_bf16 v34, v20, v83
    v_dot2c_f32_bf16 v35, v21, v83
    s_waitcnt vmcnt(6)
    v_dot2c_f32_bf16 v36, v20, v84
    v_dot2c_f32_bf16 v37, v21, v84
    v_dot2c_f32_bf16 v38, v20, v85
    v_dot2c_f32_bf16 v39, v21, v85
    v_dot2c_f32_bf16 v40, v20, v86
    v_dot2c_f32_bf16 v41, v21, v86
    v_dot2c_f32_bf16 v42, v20, v87
    v_dot2c_f32_bf16 v43, v21, v87
    s_waitcnt vmcnt(5)
    v_dot2c_f32_bf16 v28, v22, v88
    v_dot2c_f32_bf16 v29, v23, v88
    v_dot2c_f32_bf16 v30, v22, v89
    v_dot2c_f32_bf16 v31, v23, v89
    v_dot2c_f32_bf16 v32, v22, v90
    v_dot2c_f32_bf16 v33, v23, v90
    v_dot2c_f32_bf16 v34, v22, v91
    v_dot2c_f32_bf16 v35, v23, v91
    s_waitcnt vmcnt(4)
    v_dot2c_f32_bf16 v36, v22, v92
    v_dot2c_f32_bf16 v37, v23, v92
    v_dot2c_f32_bf16 v38, v22, v93
    v_dot2c_f32_bf16 v39, v23, v93
    v_dot2c_f32_bf16 v40, v22, v94
    v_dot2c_f32_bf16 v41, v23, v94
    v_dot2c_f32_bf16 v42, v22, v95
    v_dot2c_f32_bf16 v43, v23, v95
    s_waitcnt vmcnt(3)
    v_dot2c_f32_bf16 v28, v24, v96
    v_dot2c_f32_bf16 v29, v25, v96
    v_dot2c_f32_bf16 v30, v24, v97
    v_dot2c_f32_bf16 v31, v25, v97
    v_dot2c_f32_bf16 v32, v24, v98
    v_dot2c_f32_bf16 v33, v25, v98
    v_dot2c_f32_bf16 v34, v24, v99
    v_dot2c_f32_bf16 v35, v25, v99
    s_waitcnt vmcnt(2)
    v_dot2c_f32_bf16 v36, v24, v100
    v_dot2c_f32_bf16 v37, v25, v100
    v_dot2c_f32_bf16 v38, v24, v101
    v_dot2c_f32_bf16 v39, v25, v101
    v_dot2c_f32_bf16 v40, v24, v102
    v_dot2c_f32_bf16 v41, v25, v102
    v_dot2c_f32_bf16 v42, v24, v103
    v_dot2c_f32_bf16 v43, v25, v103
    s_waitcnt vmcnt(1)
    v_dot2c_f32_bf16 v28, v26, v104
    v_dot2c_f32_bf16 v29, v27, v104
    v_dot2c_f32_bf16 v30, v26, v105
    v_dot2c_f32_bf16 v31, v27, v105
    v_dot2c_f32_bf16 v32, v26, v106
    v_dot2c_f32_bf16 v33, v27, v106
    v_dot2c_f32_bf16 v34, v26, v107
    v_dot2c_f32_bf16 v35, v27, v107
    s_waitcnt vmcnt(0)
    v_dot2c_f32_bf16 v36, v26, v108
    v_dot2c_f32_bf16 v37, v27, v108
    v_dot2c_f32_bf16 v38, v26, v109
    v_dot2c_f32_bf16 v39, v27, v109
    v_dot2c_f32_bf16 v40, v26, v110
    v_dot2c_f32_bf16 v41, v27, v110
    v_dot2c_f32_bf16 v42, v26, v111
    v_dot2c_f32_bf16 v43, v27, v111
    v_permlane32_swap_b32 v28, v32
    v_permlane32_swap_b32 v29, v33
    v_permlane32_swap_b32 v30, v34
    v_permlane32_swap_b32 v31, v35
    v_permlane32_swap_b32 v36, v40
    v_permlane32_swap_b32 v37, v41
    v_permlane32_swap_b32 v38, v42
    v_permlane32_swap_b32 v39, v43
    v_add_f32 v28, v28, v32
    v_add_f32 v29, v29, v33
    v_add_f32 v30, v30, v34
    v_add_f32 v31, v31, v35
    v_add_f32 v36, v36, v40
    v_add_f32 v37, v37, v41
    v_add_f32 v38, v38, v42
    v_add_f32 v39, v39, v43
    v_permlane16_swap_b32 v28, v30
    v_permlane16_swap_b32 v29, v31
    v_permlane16_swap_b32 v36, v38
    v_permlane16_swap_b32 v37, v39
    v_add_f32 v28, v28, v30
    v_add_f32 v29, v29, v31
    v_add_f32 v36, v36, v38
    v_add_f32 v37, v37, v39
    s_nop 0
    v_add_f32_dpp v44, v28, v28 row_ror:8 row_mask:0xf bank_mask:0x3
    v_add_f32_dpp v44, v29, v29 row_ror:8 row_mask:0xf bank_mask:0xc
    v_add_f32_dpp v45, v36, v36 row_ror:8 row_mask:0xf bank_mask:0x3
    v_add_f32_dpp v45, v37, v37 row_ror:8 row_mask:0xf bank_mask:0xc
    ds_write_b64 v5, v[44:45]
    s_waitcnt vmcnt(0)
    s_mov_b64 exec, 1
    ds_add_rtn_u32 v46, v4, v46
    s_mov_b64 exec, -1
    ds_read_b128 v[28:31], v2
    ds_read_b128 v[32:35], v2 offset:16
    s_waitcnt lgkmcnt(2)
    v_readfirstlane_b32 s24, v46
    s_cmp_lg_u32 s24, 3
    s_cbranch_scc1 L_exit
    s_cmp_lt_u32 s18, 4
    s_waitcnt lgkmcnt(0)
    v_pk_add_f32 v[28:29], v[28:29], v[30:31]
    v_pk_add_f32 v[32:33], v[32:33], v[34:35]
    v_pk_add_f32 v[112:113], v[28:29], v[32:33]
    buffer_store_dwordx4 v[112:115], v3, s[20:23], s50 offen
    v_mov_b32 v116, v112
    v_mov_b32 v117, v113
    s_cbranch_scc1 L_pub
    ds_write_b64 v4, v[118:119] offset:8
    s_cmp_lg_u32 s55, 0
    s_cbranch_scc1 L_loop7
L_loop3:
    buffer_load_dwordx4 v[48:51], v3, s[20:23], s51 offen offset:0 sc1
    buffer_load_dwordx4 v[52:55], v3, s[20:23], s52 offen offset:0 sc1
    buffer_load_dwordx4 v[56:59], v3, s[20:23], s53 offen offset:0 sc1
    s_sub_u32 s35, s35, 1
    s_cbranch_scc1 L_exit
    s_waitcnt vmcnt(2)
    v_cmpx_eq_u64 vcc, s[36:37], v[50:51]
    s_waitcnt vmcnt(1)
    v_cmpx_eq_u64 vcc, s[36:37], v[54:55]
    s_waitcnt vmcnt(0)
    v_cmpx_eq_u64 vcc, s[36:37], v[58:59]
    s_cmp_eq_u64 vcc, -1
    s_mov_b64 exec, -1
    s_cbranch_scc1 L_ok3
    s_cmp_gt_u32 s35, 131055
    s_cbranch_scc1 L_loop3
    s_cmp_lg_u32 s35, 131055
    s_cbranch_scc1 L_tog3
    buffer_store_dwordx4 v[116:119], v3, s[20:23], s40 offen sc1
L_tog3:
    s_xor_b32 s36, s36, s38
    s_xor_b32 s51, s51, 0x200
    s_xor_b32 s52, s52, 0x200
    s_xor_b32 s53, s53, 0x200
    s_branch L_loop3
L_ok3:
    v_pk_add_f32 v[28:29], v[112:113], v[48:49]
    v_pk_add_f32 v[30:31], v[52:53], v[56:57]
    v_pk_add_f32 v[28:29], v[28:29], v[30:31]
L_h:
    v_cvt_pk_bf16_f32 v28, v28, v29
    v_and_b32 v29, 0xffff0000, v28
    v_lshlrev_b32 v28, 16, v28
    v_mul_f32 v30, 0xbfb8aa3b, v28
    v_exp_f32 v30, v30
    s_nop 0
    v_add_f32 v30, 1.0, v30
    v_rcp_f32 v30, v30
    s_nop 0
    v_mul_f32 v30, v28, v30
    v_cvt_pk_bf16_f32 v30, v30, v30
    v_lshlrev_b32 v30, 16, v30
    v_mul_f32 v30, v30, v29
    v_cvt_pk_bf16_f32 v30, v30, v30
    ds_write_b16 v1, v30 offset:2112
    s_waitcnt lgkmcnt(0)
    s_barrier
    s_cmp_lg_u32 s34, 0
    s_cbranch_scc1 L_exit
    s_mov_b64 exec, 1
    s_mov_b64 s[24:25], s[14:15]
    s_mov_b32 s26, 4
    s_barrier
L_rd:
    buffer_load_dword v8, off, s[24:27], 0 sc1
    s_waitcnt vmcnt(0)
    v_cmp_gt_u32 vcc, 64, v8
    s_cbranch_vccz L_upd
    s_sleep 8
    s_sub_u32 s35, s35, 1
    s_cbranch_scc0 L_rd
    s_endpgm
L_upd:
    buffer_store_dwordx2 v[118:119], off, s[20:23], s48 sc1
    s_endpgm
L_pub:
    buffer_store_dwordx4 v[116:119], v3, s[20:23], s40 offen sc1
L_exit:
    s_endpgm
L_loop7:
    buffer_load_dwordx4 v[48:51], v3, s[20:23], s51 offen offset:0 sc1
    buffer_load_dwordx4 v[52:55], v3, s[20:23], s52 offen offset:0 sc1
    buffer_load_dwordx4 v[56:59], v3, s[20:23], s53 offen offset:0 sc1
    buffer_load_dwordx4 v[60:63], v3, s[20:23], s54 offen offset:0 sc1
    buffer_load_dwordx4 v[64:67], v3, s[20:23], s54 offen offset:2048 sc1
    buffer_load_dwordx4 v[68:71], v3, s[20:23], s49 offen offset:0 sc1
    buffer_load_dwordx4 v[72:75], v3, s[20:23], s49 offen offset:2048 sc1
    s_sub_u32 s35, s35, 1
    s_cbranch_scc1 L_exit
    s_waitcnt vmcnt(6)
    v_cmpx_eq_u64 vcc, s[36:37], v[50:51]
    s_waitcnt vmcnt(5)
    v_cmpx_eq_u64 vcc, s[36:37], v[54:55]
    s_waitcnt vmcnt(4)
    v_cmpx_eq_u64 vcc, s[36:37], v[58:59]
    s_waitcnt vmcnt(3)
    v_cmpx_eq_u64 vcc, s[36:37], v[62:63]
    s_waitcnt vmcnt(2)
    v_cmpx_eq_u64 vcc, s[36:37], v[66:67]
    s_waitcnt vmcnt(1)
    v_cmpx_eq_u64 vcc, s[36:37], v[70:71]
    s_waitcnt vmcnt(0)
    v_cmpx_eq_u64 vcc, s[36:37], v[74:75]
    s_cmp_eq_u64 vcc, -1
    s_mov_b64 exec, -1
    s_cbranch_scc1 L_ok7
    s_cmp_gt_u32 s35, 131055
    s_cbranch_scc1 L_loop7
    s_cmp_lg_u32 s35, 131055
    s_cbranch_scc1 L_tog7
    buffer_store_dwordx4 v[116:119], v3, s[20:23], s40 offen sc1
L_tog7:
    s_xor_b32 s36, s36, s38
    s_xor_b32 s51, s51, 0x200
    s_xor_b32 s52, s52, 0x200
    s_xor_b32 s53, s53, 0x200
    s_xor_b32 s54, s54, 0x200
    s_xor_b32 s49, s49, 0x200
    s_branch L_loop7
L_ok7:
    v_pk_add_f32 v[60:61], v[60:61], v[64:65]
    v_pk_add_f32 v[68:69], v[68:69], v[72:73]
    v_pk_add_f32 v[28:29], v[112:113], v[48:49]
    v_pk_add_f32 v[30:31], v[52:53], v[56:57]
    v_pk_add_f32 v[60:61], v[60:61], v[68:69]
    v_pk_add_f32 v[28:29], v[28:29], v[30:31]
    v_pk_add_f32 v[28:29], v[28:29], v[60:61]
    s_branch L_h
L_hi:
    s_sub_u32 s33, s33, 4
    s_cmp_lt_u32 s18, 4
    s_cbranch_scc1 L_cons
    s_xor_b32 s33, s33, 3
    s_lshl_b32 s24, s19, 17
    s_lshl_b32 s25, s34, 9
    s_add_u32 s24, s24, s25
    s_lshl_b32 s25, s33, 7
    s_add_u32 s24, s24, s25
    v_bfe_u32 v5, v0, 3, 3
    v_lshlrev_b32 v7, 14, v5
    v_lshlrev_b32 v6, 4, v5
    v_and_b32 v5, 7, v0
    v_lshlrev_b32 v5, 4, v5
    v_add3_u32 v3, v7, v5, s24
    v_bfe_u32 v7, v0, 4, 2
    v_lshl_add_u32 v4, v7, 13, v5
    s_lshl_b32 s24, s34, 2
    s_add_u32 s24, s24, s33
    s_lshl_b32 s24, s24, 15
    s_lshl_b32 s25, s3, 10
    s_add_u32 s24, s24, s25
    s_lshr_b32 s25, s18, 2
    s_cmp_lt_u32 s25, 4
    s_subb_u32 s25, s25, 0
    s_lshl_b32 s25, s25, 7
    s_add_u32 s24, s24, s25
    s_add_u32 s54, s24, 589824
    v_mov_b32 v2, 0
    s_mov_b32 s52, 0x00ff00ff
    s_mov_b32 s53, s52
    s_mov_b32 s50, 0x05040100
    s_mov_b32 s51, 0x07060302
    v_and_b32 v6, 1, v0
    v_lshl_add_u32 v6, v7, 1, v6
    v_lshlrev_b32 v6, 4, v6
    s_movk_i32 s41, 4096
    s_movk_i32 s42, 8192
    s_movk_i32 s43, 12288
    s_mov_b32 s26, 7340032
    s_mov_b32 s27, 0x20000
    s_mov_b32 s30, 1114112
    s_mov_b32 s31, 0x20000
    s_waitcnt lgkmcnt(0)
    s_mov_b64 s[24:25], s[10:11]
    s_mov_b64 s[28:29], s[16:17]
    s_barrier
    buffer_load_dwordx4 v[64:67], v3, s[24:27], 0 offen offset:0 nt
    buffer_load_dwordx4 v[68:71], v3, s[24:27], 0 offen offset:2048 nt
    buffer_load_dwordx4 v[72:75], v3, s[24:27], s41 offen offset:0 nt
    buffer_load_dwordx4 v[76:79], v3, s[24:27], s41 offen offset:2048 nt
    buffer_load_dwordx4 v[80:83], v3, s[24:27], s42 offen offset:0 nt
    buffer_load_dwordx4 v[84:87], v3, s[24:27], s42 offen offset:2048 nt
    buffer_load_dwordx4 v[88:91], v3, s[24:27], s43 offen offset:0 nt
    buffer_load_dwordx4 v[92:95], v3, s[24:27], s43 offen offset:2048 nt
    s_waitcnt vmcnt(6)
    v_perm_b32 v8, v68, v64, s50
    v_perm_b32 v12, v68, v64, s51
    v_perm_b32 v16, v69, v65, s50
    v_perm_b32 v20, v69, v65, s51
    v_perm_b32 v24, v70, v66, s50
    v_perm_b32 v28, v70, v66, s51
    v_perm_b32 v32, v71, v67, s50
    v_perm_b32 v36, v71, v67, s51
    s_waitcnt vmcnt(4)
    v_perm_b32 v9, v76, v72, s50
    v_perm_b32 v13, v76, v72, s51
    v_perm_b32 v17, v77, v73, s50
    v_perm_b32 v21, v77, v73, s51
    v_perm_b32 v25, v78, v74, s50
    v_perm_b32 v29, v78, v74, s51
    v_perm_b32 v33, v79, v75, s50
    v_perm_b32 v37, v79, v75, s51
    s_waitcnt vmcnt(2)
    v_perm_b32 v10, v84, v80, s50
    v_perm_b32 v14, v84, v80, s51
    v_perm_b32 v18, v85, v81, s50
    v_perm_b32 v22, v85, v81, s51
    v_perm_b32 v26, v86, v82, s50
    v_perm_b32 v30, v86, v82, s51
    v_perm_b32 v34, v87, v83, s50
    v_perm_b32 v38, v87, v83, s51
    s_waitcnt vmcnt(0)
    v_perm_b32 v11, v92, v88, s50
    v_perm_b32 v15, v92, v88, s51
    v_perm_b32 v19, v93, v89, s50
    v_perm_b32 v23, v93, v89, s51
    v_perm_b32 v27, v94, v90, s50
    v_perm_b32 v31, v94, v90, s51
    v_perm_b32 v35, v95, v91, s50
    v_perm_b32 v39, v95, v91, s51
    s_barrier
    ds_read_b128 v[56:59], v6 offset:2112
    ds_read_b64 v[42:43], v2 offset:2056
    s_waitcnt lgkmcnt(1)
    v_mfma_f32_16x16x32_bf16 v[64:67], v[56:59], v[8:11], 0
    v_mfma_f32_16x16x32_bf16 v[68:71], v[56:59], v[12:15], 0
    v_mfma_f32_16x16x32_bf16 v[72:75], v[56:59], v[16:19], 0
    v_mfma_f32_16x16x32_bf16 v[76:79], v[56:59], v[20:23], 0
    v_mfma_f32_16x16x32_bf16 v[80:83], v[56:59], v[24:27], 0
    v_mfma_f32_16x16x32_bf16 v[84:87], v[56:59], v[28:31], 0
    v_mfma_f32_16x16x32_bf16 v[88:91], v[56:59], v[32:35], 0
    v_mfma_f32_16x16x32_bf16 v[92:95], v[56:59], v[36:39], 0
    s_nop 0
    v_add_f32_dpp v40, v65, v64 row_shl:8 row_mask:0x1 bank_mask:0x3
    v_add_f32_dpp v41, v69, v68 row_shl:8 row_mask:0x1 bank_mask:0x3
    v_add_f32_dpp v40, v73, v72 row_shl:8 row_mask:0x2 bank_mask:0x3
    v_add_f32_dpp v41, v77, v76 row_shl:8 row_mask:0x2 bank_mask:0x3
    v_add_f32_dpp v40, v81, v80 row_shl:8 row_mask:0x4 bank_mask:0x3
    v_add_f32_dpp v41, v85, v84 row_shl:8 row_mask:0x4 bank_mask:0x3
    v_add_f32_dpp v40, v89, v88 row_shl:8 row_mask:0x8 bank_mask:0x3
    v_add_f32_dpp v41, v93, v92 row_shl:8 row_mask:0x8 bank_mask:0x3
    s_mov_b64 exec, s[52:53]
    s_waitcnt lgkmcnt(0)
    buffer_store_dwordx4 v[40:43], v4, s[28:31], s54 offen sc1
    s_endpgm
L_cons:
    s_cmp_ge_u32 s33, 2
    s_cbranch_scc1 L_done2
    s_barrier
    s_lshl_b32 s24, s2, 1
    s_add_u32 s24, s24, s33
    s_lshl_b32 s41, s24, 13
    s_add_u32 s41, s41, 589824
    s_add_u32 s42, s41, 4096
    s_waitcnt lgkmcnt(0)
    v_and_b32 v5, 63, v0
    v_lshrrev_b32 v6, 3, v5
    v_lshrrev_b32 v7, 5, v5
    v_sub_u32 v6, v6, v7
    v_lshlrev_b32 v2, 3, v6
    v_lshlrev_b32 v3, 4, v5
    v_and_b32 v4, 7, v0
    v_bfe_u32 v6, v0, 5, 1
    v_lshl_add_u32 v4, v4, 3, v6
    s_and_b32 s25, s24, 3
    s_lshr_b32 s24, s24, 2
    s_lshl_b32 s24, s24, 5
    s_add_u32 s24, s24, s25
    s_lshl_b32 s24, s24, 2
    v_lshl_add_u32 v4, v4, 1, s24
    s_mov_b64 s[20:21], s[16:17]
    s_mov_b64 s[36:37], s[12:13]
    s_mov_b32 s44, 0x00ffffff
    s_mov_b32 s45, -1
    s_mov_b32 s35, 0x40000
    s_mov_b32 s22, 1114112
    s_mov_b32 s23, 0x20000
    s_mov_b32 s38, 2048
    s_mov_b32 s39, 0x20000
    v_mov_b32 v40, 0
    v_mov_b32 v41, 0
    s_mov_b64 s[28:29], s[14:15]
    s_mov_b32 s30, 4
    s_mov_b32 s31, 0x20000
    v_mov_b32 v6, 1
    s_mov_b64 exec, s[44:45]
    buffer_load_dwordx2 v[48:49], v2, s[20:23], 0 offen offset:0
    buffer_load_dwordx2 v[50:51], v2, s[20:23], 0 offen offset:256
    buffer_load_dwordx2 v[52:53], v2, s[20:23], 0 offen offset:512
    buffer_load_dwordx2 v[54:55], v2, s[20:23], 0 offen offset:768
    buffer_load_dwordx2 v[56:57], v2, s[20:23], 0 offen offset:1024
    buffer_load_dwordx2 v[58:59], v2, s[20:23], 0 offen offset:1280
    buffer_load_dwordx2 v[60:61], v2, s[20:23], 0 offen offset:1536
    buffer_load_dwordx2 v[62:63], v2, s[20:23], 0 offen offset:1792
    s_waitcnt vmcnt(0)
    s_mov_b64 exec, 1
    buffer_atomic_add v6, off, s[28:31], 0 sc1
    s_mov_b64 exec, s[44:45]
    buffer_load_dwordx4 v[12:15], v3, s[20:23], s41 offen offset:1024 sc1 nt
    buffer_load_dwordx4 v[16:19], v3, s[20:23], s41 offen offset:2048 sc1 nt
    buffer_load_dwordx4 v[20:23], v3, s[20:23], s41 offen offset:3072 sc1 nt
    buffer_load_dwordx4 v[24:27], v3, s[20:23], s42 offen offset:0 sc1 nt
    buffer_load_dwordx4 v[28:31], v3, s[20:23], s42 offen offset:1024 sc1 nt
    buffer_load_dwordx4 v[32:35], v3, s[20:23], s42 offen offset:2048 sc1 nt
    buffer_load_dwordx4 v[36:39], v3, s[20:23], s42 offen offset:3072 sc1 nt
    v_add_u32 v48, 2135587861, v48
    v_add_u32 v49, 2654435769, v49
    v_add_u32 v50, 2135587861, v50
    v_add_u32 v51, 2654435769, v51
    v_add_u32 v52, 2135587861, v52
    v_add_u32 v53, 2654435769, v53
    v_add_u32 v54, 2135587861, v54
    v_add_u32 v55, 2654435769, v55
    v_add_u32 v56, 2135587861, v56
    v_add_u32 v57, 2654435769, v57
    v_add_u32 v58, 2135587861, v58
    v_add_u32 v59, 2654435769, v59
    v_add_u32 v60, 2135587861, v60
    v_add_u32 v61, 2654435769, v61
    v_add_u32 v62, 2135587861, v62
    v_add_u32 v63, 2654435769, v63
L_pa:
    s_sub_u32 s35, s35, 1
    s_cbranch_scc1 L_done2
    buffer_load_dwordx4 v[8:11], v3, s[20:23], s41 offen sc1
    s_waitcnt vmcnt(0)
    v_cmp_eq_u64 vcc, v[48:49], v[10:11]
    s_cbranch_vccz L_pa
L_is0:
    buffer_load_dwordx4 v[8:11], v3, s[20:23], s41 offen offset:0 sc1
L_is1:
    buffer_load_dwordx4 v[12:15], v3, s[20:23], s41 offen offset:1024 sc1
L_is2:
    buffer_load_dwordx4 v[16:19], v3, s[20:23], s41 offen offset:2048 sc1
L_is3:
    buffer_load_dwordx4 v[20:23], v3, s[20:23], s41 offen offset:3072 sc1
L_is4:
    buffer_load_dwordx4 v[24:27], v3, s[20:23], s42 offen offset:0 sc1
L_is5:
    buffer_load_dwordx4 v[28:31], v3, s[20:23], s42 offen offset:1024 sc1
L_is6:
    buffer_load_dwordx4 v[32:35], v3, s[20:23], s42 offen offset:2048 sc1
L_is7:
    buffer_load_dwordx4 v[36:39], v3, s[20:23], s42 offen offset:3072 sc1
    s_sub_u32 s35, s35, 1
    s_cbranch_scc1 L_done2
    s_waitcnt vmcnt(7)
    v_cmp_ne_u64 vcc, v[48:49], v[10:11]
    s_cbranch_vccnz L_is0
    s_waitcnt vmcnt(6)
    v_cmp_ne_u64 vcc, v[50:51], v[14:15]
    s_cbranch_vccnz L_is1
    v_pk_add_f32 v[40:41], v[8:9], v[12:13]
    s_waitcnt vmcnt(5)
    v_cmp_ne_u64 vcc, v[52:53], v[18:19]
    s_cbranch_vccnz L_is2
    v_pk_add_f32 v[40:41], v[40:41], v[16:17]
    s_waitcnt vmcnt(4)
    v_cmp_ne_u64 vcc, v[54:55], v[22:23]
    s_cbranch_vccnz L_is3
    v_pk_add_f32 v[40:41], v[40:41], v[20:21]
    s_waitcnt vmcnt(3)
    v_cmp_ne_u64 vcc, v[56:57], v[26:27]
    s_cbranch_vccnz L_is4
    v_pk_add_f32 v[40:41], v[40:41], v[24:25]
    s_waitcnt vmcnt(2)
    v_cmp_ne_u64 vcc, v[58:59], v[30:31]
    s_cbranch_vccnz L_is5
    v_pk_add_f32 v[40:41], v[40:41], v[28:29]
    s_waitcnt vmcnt(1)
    v_cmp_ne_u64 vcc, v[60:61], v[34:35]
    s_cbranch_vccnz L_is6
    v_pk_add_f32 v[40:41], v[40:41], v[32:33]
    s_waitcnt vmcnt(0)
    v_cmp_ne_u64 vcc, v[62:63], v[38:39]
    s_cbranch_vccnz L_is7
    v_pk_add_f32 v[40:41], v[40:41], v[36:37]
    s_mov_b32 exec_lo, -1
L_cs:
    s_nop 0
    v_permlane32_swap_b32 v40, v41
    s_nop 0
    v_add_f32 v40, v40, v41
    s_nop 1
    v_add_f32_dpp v40, v40, v40 row_ror:8 row_mask:0xf bank_mask:0xf
    s_nop 1
    v_permlane16_swap_b32 v40, v41
    s_mov_b32 exec_lo, 0xff
    s_mov_b32 exec_hi, 0xff
    v_add_f32 v40, v40, v41
    v_cvt_pk_bf16_f32 v40, v40, v40
    buffer_store_short v40, v4, s[36:39], 0 offen
L_done2:
    s_endpgm
.section .rodata,"a"
.p2align 6
.amdhsa_kernel standalone__glu_gated_swiglu__decode_kernel
  .amdhsa_next_free_vgpr 128
  .amdhsa_next_free_sgpr 64
  .amdhsa_accum_offset 128
  .amdhsa_group_segment_fixed_size 0
  .amdhsa_float_denorm_mode_32 3
  .amdhsa_kernarg_size 56
  .amdhsa_user_sgpr_count 2
  .amdhsa_user_sgpr_kernarg_segment_ptr 1
  .amdhsa_system_sgpr_workgroup_id_x 1
.end_amdhsa_kernel
```
